```python
import torch

def _softmax(x, axis=-1):
    return torch.softmax(x, dim=axis)
def _gelu(x):
    return torch.nn.functional.gelu(x, approximate="tanh")
def _silu(x):
    return torch.nn.functional.silu(x)
def _sigmoid(x):
    return torch.sigmoid(x)
def _layernorm(x, axis=-1, eps=1e-5):
    m = x.mean(dim=axis, keepdim=True)
    v = x.var(dim=axis, keepdim=True, unbiased=False)
    return (x - m) / torch.sqrt(v + eps)
def _scatter_add(tgt, idx, src, axis=0):
    return tgt.clone().index_add_(axis, idx, src)
def _segment_sum(src, seg, n):
    out = torch.zeros((n,) + src.shape[1:], dtype=src.dtype)
    return out.index_add_(0, seg, src)
def _pad(x, pw):
    flat = tuple(v for pair in reversed(pw) for v in pair)
    return torch.nn.functional.pad(x, flat)

kernel_name = 'standalone__sliding_block_cached__decode'

def setup_inputs():

    _w = (lambda a: (lambda t: t.to(torch.bfloat16) if t.is_floating_point() else t)(torch.as_tensor(a)))
    B, Sq, D = 1, 1, 640
    Hq, Hkv, Sk, Dh = 32, 32, 16384, 128
    assert Hq % Hkv == 0, (Hq, Hkv)
    return {
        "x": _w((lambda *s: torch.randn(*s, dtype=torch.bfloat16) * 0.8)(B, Sq, D)),
        "k_cache": _w((lambda *s: torch.randn(*s, dtype=torch.bfloat16) * 0.8)(B, Hkv, Sk, Dh)),
        "v_cache": _w((lambda *s: torch.randn(*s, dtype=torch.bfloat16) * 0.05)(B, Hkv, Sk, Dh)),
        "wq": _w((lambda *s: torch.randn(*s, dtype=torch.bfloat16) * 0.8)(D, Hq * Dh) * (D ** -0.5)),
        "wo": _w((lambda *s: torch.randn(*s, dtype=torch.bfloat16) * 0.05)(Hq * Dh, D) * ((Hq * Dh) ** -0.5)),
    }

def reference(x, k_cache, v_cache, wq, wo):
    B, Sq, D = x.shape
    Hq, Dh = 32, 128
    Hkv, Sk = k_cache.shape[1], k_cache.shape[2]
    W = min(4096, max(256, Sk // 4))
    rep = Hq // Hkv
    q = (lambda x, *d: x.permute(*d))((x @ wq).reshape(B, Sq, Hq, Dh), 0, 2, 1, 3)
    k = (lambda x, n, axis: torch.repeat_interleave(x, n, dim=axis))(k_cache[:, :, Sk - W:, :], rep, axis=1)
    v = (lambda x, n, axis: torch.repeat_interleave(x, n, dim=axis))(v_cache[:, :, Sk - W:, :], rep, axis=1)
    scores = torch.einsum("bhqd,bhkd->bhqk", q, k) * (Dh ** -0.5)
    p = _softmax(scores, axis=-1)
    o = torch.einsum("bhqk,bhkd->bhqd", p, v)
    return (lambda x, *d: x.permute(*d))(o, 0, 2, 1, 3).reshape(B, Sq, Hq * Dh) @ wo
```

```asm
; @launch grid=(256,1,1) block=(576,1,1) lds=16384
.amdgcn_target "amdgcn-amd-amdhsa--gfx950"
.text
.globl standalone__sliding_block_cached__decode_kernel
.p2align 8
.type standalone__sliding_block_cached__decode_kernel,@function
standalone__sliding_block_cached__decode_kernel:
    s_cmp_ge_u32 s2, 256
    s_cbranch_scc1 L_exit
    s_load_dwordx16 s[16:31], s[0:1], 0
    v_lshrrev_b32 v3, 6, v0
    v_and_b32 v0, 63, v0
    v_readfirstlane_b32 s5, v3
    s_and_b32 s3, s2, 31
    s_lshr_b32 s4, s2, 5
    s_mov_b32 s71, 0x8000
    s_mov_b32 s72, 0x10000
    s_mov_b32 s73, 0x18000
    s_movk_i32 s77, 0x2000
    s_mov_b32 s74, 0x3db504f3
    s_mov_b32 s75, 0x3fb8aa3b
    s_cmp_eq_u32 s5, 8
    s_cbranch_scc1 L_sync
    v_and_b32 v12, 15, v0
    v_lshrrev_b32 v13, 4, v0
    v_lshl_add_u32 v14, v3, 4, v12
    v_lshlrev_b32 v14, 8, v14
    v_lshl_add_u32 v1, v13, 4, v14
    v_lshlrev_b32 v14, 4, v12
    v_lshl_add_u32 v14, v3, 12, v14
    v_lshl_add_u32 v2, v13, 10, v14
    s_lshl_b32 s6, s3, 22
    s_lshl_b32 s7, s4, 17
    s_add_u32 s6, s6, s7
    s_add_u32 s6, s6, 0x300000
    s_waitcnt lgkmcnt(0)
    s_add_u32 s36, s18, s6
    s_addc_u32 s37, s19, 0
    s_and_b32 s37, s37, 0xffff
    s_mov_b32 s38, 0x20000
    s_mov_b32 s39, 0x00020000
    s_add_u32 s40, s20, s6
    s_addc_u32 s41, s21, 0
    s_and_b32 s41, s41, 0xffff
    s_mov_b32 s42, 0x20000
    s_mov_b32 s43, 0x00020000
    s_barrier
    buffer_load_dwordx4 v[104:107], v2, s[40:43], 0 offen offset:0 nt
    buffer_load_dwordx4 v[108:111], v2, s[40:43], 0 offen offset:256 nt
    buffer_load_dwordx4 v[112:115], v2, s[40:43], 0 offen offset:512 nt
    buffer_load_dwordx4 v[116:119], v2, s[40:43], 0 offen offset:768 nt
    buffer_load_dwordx4 v[40:43], v1, s[36:39], 0 offen offset:0 nt
    buffer_load_dwordx4 v[44:47], v1, s[36:39], 0 offen offset:64 nt
    buffer_load_dwordx4 v[48:51], v1, s[36:39], 0 offen offset:128 nt
    buffer_load_dwordx4 v[52:55], v1, s[36:39], 0 offen offset:192 nt
    s_mov_b32 s60, s30
    s_and_b32 s61, s31, 0xffff
    s_mov_b32 s62, 0x400000
    s_mov_b32 s63, 0x00020000
    s_mul_i32 s7, s3, 0x28000
    s_mul_i32 s8, s4, 160
    s_add_u32 s7, s7, s8
    s_sub_u32 s8, 0x500000, s7
    s_add_u32 s48, s24, s7
    s_addc_u32 s49, s25, 0
    s_and_b32 s49, s49, 0xffff
    s_mov_b32 s50, s8
    s_mov_b32 s51, 0x00020000
    s_barrier
    buffer_load_dwordx4 v[56:59], v1, s[36:39], s71 offen offset:0 nt
    buffer_load_dwordx4 v[60:63], v1, s[36:39], s71 offen offset:64 nt
    buffer_load_dwordx4 v[64:67], v1, s[36:39], s71 offen offset:128 nt
    buffer_load_dwordx4 v[68:71], v1, s[36:39], s71 offen offset:192 nt
    buffer_load_dwordx4 v[72:75], v1, s[36:39], s72 offen offset:0 nt
    buffer_load_dwordx4 v[76:79], v1, s[36:39], s72 offen offset:64 nt
    buffer_load_dwordx4 v[80:83], v1, s[36:39], s72 offen offset:128 nt
    buffer_load_dwordx4 v[84:87], v1, s[36:39], s72 offen offset:192 nt
    s_barrier
    buffer_load_dwordx4 v[88:91], v1, s[36:39], s73 offen offset:0 nt
    buffer_load_dwordx4 v[92:95], v1, s[36:39], s73 offen offset:64 nt
    buffer_load_dwordx4 v[96:99], v1, s[36:39], s73 offen offset:128 nt
    buffer_load_dwordx4 v[100:103], v1, s[36:39], s73 offen offset:192 nt
    buffer_load_dwordx4 v[120:123], v2, s[40:43], s71 offen offset:0 nt
    buffer_load_dwordx4 v[124:127], v2, s[40:43], s71 offen offset:256 nt
    buffer_load_dwordx4 v[128:131], v2, s[40:43], s71 offen offset:512 nt
    buffer_load_dwordx4 v[132:135], v2, s[40:43], s71 offen offset:768 nt
    s_barrier
    v_lshrrev_b32 v13, 4, v0
    v_lshlrev_b32 v13, 4, v13
    ds_read_b128 v[24:27], v13 offset:0
    ds_read_b128 v[28:31], v13 offset:64
    ds_read_b128 v[32:35], v13 offset:128
    ds_read_b128 v[36:39], v13 offset:192
    s_waitcnt lgkmcnt(0)
    s_waitcnt vmcnt(4)
    v_mfma_f32_16x16x32_bf16 v[20:23], v[40:43], v[24:27], 0
    v_mfma_f32_16x16x32_bf16 v[20:23], v[44:47], v[28:31], v[20:23]
    v_mfma_f32_16x16x32_bf16 v[20:23], v[48:51], v[32:35], v[20:23]
    v_mfma_f32_16x16x32_bf16 v[20:23], v[52:55], v[36:39], v[20:23]
    v_mfma_f32_16x16x32_bf16 v[40:43], v[56:59], v[24:27], 0
    v_mfma_f32_16x16x32_bf16 v[40:43], v[60:63], v[28:31], v[40:43]
    v_mfma_f32_16x16x32_bf16 v[40:43], v[64:67], v[32:35], v[40:43]
    v_mfma_f32_16x16x32_bf16 v[40:43], v[68:71], v[36:39], v[40:43]
    v_mfma_f32_16x16x32_bf16 v[56:59], v[72:75], v[24:27], 0
    v_mfma_f32_16x16x32_bf16 v[56:59], v[76:79], v[28:31], v[56:59]
    v_mfma_f32_16x16x32_bf16 v[56:59], v[80:83], v[32:35], v[56:59]
    v_mfma_f32_16x16x32_bf16 v[56:59], v[84:87], v[36:39], v[56:59]
    v_mfma_f32_16x16x32_bf16 v[72:75], v[88:91], v[24:27], 0
    v_mfma_f32_16x16x32_bf16 v[72:75], v[92:95], v[28:31], v[72:75]
    v_mfma_f32_16x16x32_bf16 v[72:75], v[96:99], v[32:35], v[72:75]
    v_mfma_f32_16x16x32_bf16 v[72:75], v[100:103], v[36:39], v[72:75]
    s_nop 7
    s_nop 1
    buffer_load_dwordx4 v[136:139], v2, s[40:43], s72 offen offset:0 nt
    buffer_load_dwordx4 v[140:143], v2, s[40:43], s72 offen offset:256 nt
    buffer_load_dwordx4 v[144:147], v2, s[40:43], s72 offen offset:512 nt
    buffer_load_dwordx4 v[148:151], v2, s[40:43], s72 offen offset:768 nt
    buffer_load_dwordx4 v[152:155], v2, s[40:43], s73 offen offset:0 nt
    buffer_load_dwordx4 v[156:159], v2, s[40:43], s73 offen offset:256 nt
    buffer_load_dwordx4 v[160:163], v2, s[40:43], s73 offen offset:512 nt
    buffer_load_dwordx4 v[164:167], v2, s[40:43], s73 offen offset:768 nt
    v_cvt_pk_bf16_f32 v24, v20, v21
    v_cvt_pk_bf16_f32 v25, v22, v23
    v_cvt_pk_bf16_f32 v26, v40, v41
    v_cvt_pk_bf16_f32 v27, v42, v43
    v_cvt_pk_bf16_f32 v28, v56, v57
    v_cvt_pk_bf16_f32 v29, v58, v59
    v_cvt_pk_bf16_f32 v30, v72, v73
    v_cvt_pk_bf16_f32 v31, v74, v75
    v_lshlrev_b32 v20, 16, v24
    v_and_b32 v21, 0xffff0000, v24
    v_lshlrev_b32 v22, 16, v25
    v_and_b32 v23, 0xffff0000, v25
    v_lshlrev_b32 v40, 16, v26
    v_and_b32 v41, 0xffff0000, v26
    v_lshlrev_b32 v42, 16, v27
    v_and_b32 v43, 0xffff0000, v27
    v_lshlrev_b32 v56, 16, v28
    v_and_b32 v57, 0xffff0000, v28
    v_lshlrev_b32 v58, 16, v29
    v_and_b32 v59, 0xffff0000, v29
    v_lshlrev_b32 v72, 16, v30
    v_and_b32 v73, 0xffff0000, v30
    v_lshlrev_b32 v74, 16, v31
    v_and_b32 v75, 0xffff0000, v31
    v_mul_f32 v20, s74, v20
    v_mul_f32 v21, s74, v21
    v_mul_f32 v22, s74, v22
    v_mul_f32 v23, s74, v23
    v_mul_f32 v40, s74, v40
    v_mul_f32 v41, s74, v41
    v_mul_f32 v42, s74, v42
    v_mul_f32 v43, s74, v43
    v_mul_f32 v56, s74, v56
    v_mul_f32 v57, s74, v57
    v_mul_f32 v58, s74, v58
    v_mul_f32 v59, s74, v59
    v_mul_f32 v72, s74, v72
    v_mul_f32 v73, s74, v73
    v_mul_f32 v74, s74, v74
    v_mul_f32 v75, s74, v75
    v_cvt_pk_bf16_f32 v24, v20, v21
    v_cvt_pk_bf16_f32 v25, v22, v23
    v_cvt_pk_bf16_f32 v26, v40, v41
    v_cvt_pk_bf16_f32 v27, v42, v43
    v_cvt_pk_bf16_f32 v28, v56, v57
    v_cvt_pk_bf16_f32 v29, v58, v59
    v_cvt_pk_bf16_f32 v30, v72, v73
    v_cvt_pk_bf16_f32 v31, v74, v75
    v_lshlrev_b32 v20, 16, v24
    v_and_b32 v21, 0xffff0000, v24
    v_lshlrev_b32 v22, 16, v25
    v_and_b32 v23, 0xffff0000, v25
    v_lshlrev_b32 v40, 16, v26
    v_and_b32 v41, 0xffff0000, v26
    v_lshlrev_b32 v42, 16, v27
    v_and_b32 v43, 0xffff0000, v27
    v_lshlrev_b32 v56, 16, v28
    v_and_b32 v57, 0xffff0000, v28
    v_lshlrev_b32 v58, 16, v29
    v_and_b32 v59, 0xffff0000, v29
    v_lshlrev_b32 v72, 16, v30
    v_and_b32 v73, 0xffff0000, v30
    v_lshlrev_b32 v74, 16, v31
    v_and_b32 v75, 0xffff0000, v31
    v_max3_f32 v12, v20, v21, v22
    v_max3_f32 v12, v12, v23, v40
    v_max3_f32 v12, v12, v41, v42
    v_max3_f32 v12, v12, v43, v56
    v_max3_f32 v12, v12, v57, v58
    v_max3_f32 v12, v12, v59, v72
    v_max3_f32 v12, v12, v73, v74
    v_max_f32 v12, v12, v75
    v_mov_b32 v13, v12
    s_nop 1
    v_permlane32_swap_b32 v12, v13
    v_max_f32 v12, v12, v13
    v_mov_b32 v13, v12
    s_nop 1
    v_permlane16_swap_b32 v12, v13
    v_max_f32 v12, v12, v13
    v_mov_b32 v16, v12
    v_mul_f32 v13, s75, v16
    v_fma_f32 v20, v20, s75, -v13
    v_fma_f32 v21, v21, s75, -v13
    v_fma_f32 v22, v22, s75, -v13
    v_fma_f32 v23, v23, s75, -v13
    v_fma_f32 v40, v40, s75, -v13
    v_fma_f32 v41, v41, s75, -v13
    v_fma_f32 v42, v42, s75, -v13
    v_fma_f32 v43, v43, s75, -v13
    v_fma_f32 v56, v56, s75, -v13
    v_fma_f32 v57, v57, s75, -v13
    v_fma_f32 v58, v58, s75, -v13
    v_fma_f32 v59, v59, s75, -v13
    v_fma_f32 v72, v72, s75, -v13
    v_fma_f32 v73, v73, s75, -v13
    v_fma_f32 v74, v74, s75, -v13
    v_fma_f32 v75, v75, s75, -v13
    v_exp_f32 v20, v20
    v_exp_f32 v21, v21
    v_exp_f32 v22, v22
    v_exp_f32 v23, v23
    v_exp_f32 v40, v40
    v_exp_f32 v41, v41
    v_exp_f32 v42, v42
    v_exp_f32 v43, v43
    v_exp_f32 v56, v56
    v_exp_f32 v57, v57
    v_exp_f32 v58, v58
    v_exp_f32 v59, v59
    v_exp_f32 v72, v72
    v_exp_f32 v73, v73
    v_exp_f32 v74, v74
    v_exp_f32 v75, v75
    s_nop 0
    v_add_f32 v18, v20, v21
    v_add_f32 v18, v18, v22
    v_add_f32 v18, v18, v23
    v_add_f32 v18, v18, v40
    v_add_f32 v18, v18, v41
    v_add_f32 v18, v18, v42
    v_add_f32 v18, v18, v43
    v_add_f32 v18, v18, v56
    v_add_f32 v18, v18, v57
    v_add_f32 v18, v18, v58
    v_add_f32 v18, v18, v59
    v_add_f32 v18, v18, v72
    v_add_f32 v18, v18, v73
    v_add_f32 v18, v18, v74
    v_add_f32 v18, v18, v75
    v_mov_b32 v13, v18
    s_nop 1
    v_permlane32_swap_b32 v18, v13
    v_add_f32 v18, v18, v13
    v_mov_b32 v13, v18
    s_nop 1
    v_permlane16_swap_b32 v18, v13
    v_add_f32 v18, v18, v13
    s_mul_i32 s9, s5, 528
    v_mov_b32 v13, s9
    v_mov_b32 v19, v16
    ds_write_b64 v13, v[18:19] offset:1536
    v_lshrrev_b32 v12, 4, v0
    v_lshlrev_b32 v12, 2, v12
    s_lshl_b32 s6, s5, 4
    v_add_u32 v12, s6, v12
    v_mul_u32_u24 v12, 0x500, v12
    v_and_b32 v13, 15, v0
    v_lshl_add_u32 v12, v13, 4, v12
    s_mov_b32 exec_lo, 0x3ff03ff
    s_mov_b32 exec_hi, 0x3ff03ff
    buffer_load_dwordx4 v[88:91], v12, s[48:51], 0 offen offset:0 nt
    buffer_load_dwordx4 v[92:95], v12, s[48:51], 0 offen offset:1280 nt
    buffer_load_dwordx4 v[96:99], v12, s[48:51], 0 offen offset:2560 nt
    buffer_load_dwordx4 v[100:103], v12, s[48:51], 0 offen offset:3840 nt
    s_mov_b64 exec, -1
    v_and_b32 v12, 15, v0
    v_lshrrev_b32 v13, 4, v0
    v_lshlrev_b32 v3, 5, v12
    v_lshl_add_u32 v3, v13, 3, v3
    s_waitcnt vmcnt(35)
    v_lshlrev_b32 v13, 16, v104
    v_and_b32 v14, 0xffff0000, v104
    v_mul_f32 v4, v13, v20
    v_mul_f32 v5, v14, v20
    v_lshlrev_b32 v13, 16, v105
    v_and_b32 v14, 0xffff0000, v105
    v_mul_f32 v6, v13, v20
    v_mul_f32 v7, v14, v20
    v_lshlrev_b32 v13, 16, v106
    v_and_b32 v14, 0xffff0000, v106
    v_mul_f32 v8, v13, v20
    v_mul_f32 v9, v14, v20
    v_lshlrev_b32 v13, 16, v107
    v_and_b32 v14, 0xffff0000, v107
    v_mul_f32 v10, v13, v20
    v_mul_f32 v11, v14, v20
    s_waitcnt vmcnt(34)
    v_lshlrev_b32 v13, 16, v108
    v_and_b32 v14, 0xffff0000, v108
    v_fmac_f32 v4, v13, v21
    v_fmac_f32 v5, v14, v21
    v_lshlrev_b32 v13, 16, v109
    v_and_b32 v14, 0xffff0000, v109
    v_fmac_f32 v6, v13, v21
    v_fmac_f32 v7, v14, v21
    v_lshlrev_b32 v13, 16, v110
    v_and_b32 v14, 0xffff0000, v110
    v_fmac_f32 v8, v13, v21
    v_fmac_f32 v9, v14, v21
    v_lshlrev_b32 v13, 16, v111
    v_and_b32 v14, 0xffff0000, v111
    v_fmac_f32 v10, v13, v21
    v_fmac_f32 v11, v14, v21
    s_waitcnt vmcnt(33)
    v_lshlrev_b32 v13, 16, v112
    v_and_b32 v14, 0xffff0000, v112
    v_fmac_f32 v4, v13, v22
    v_fmac_f32 v5, v14, v22
    v_lshlrev_b32 v13, 16, v113
    v_and_b32 v14, 0xffff0000, v113
    v_fmac_f32 v6, v13, v22
    v_fmac_f32 v7, v14, v22
    v_lshlrev_b32 v13, 16, v114
    v_and_b32 v14, 0xffff0000, v114
    v_fmac_f32 v8, v13, v22
    v_fmac_f32 v9, v14, v22
    v_lshlrev_b32 v13, 16, v115
    v_and_b32 v14, 0xffff0000, v115
    v_fmac_f32 v10, v13, v22
    v_fmac_f32 v11, v14, v22
    s_waitcnt vmcnt(32)
    v_lshlrev_b32 v13, 16, v116
    v_and_b32 v14, 0xffff0000, v116
    v_fmac_f32 v4, v13, v23
    v_fmac_f32 v5, v14, v23
    v_lshlrev_b32 v13, 16, v117
    v_and_b32 v14, 0xffff0000, v117
    v_fmac_f32 v6, v13, v23
    v_fmac_f32 v7, v14, v23
    v_lshlrev_b32 v13, 16, v118
    v_and_b32 v14, 0xffff0000, v118
    v_fmac_f32 v8, v13, v23
    v_fmac_f32 v9, v14, v23
    v_lshlrev_b32 v13, 16, v119
    v_and_b32 v14, 0xffff0000, v119
    v_fmac_f32 v10, v13, v23
    v_fmac_f32 v11, v14, v23
    s_waitcnt vmcnt(15)
    v_lshlrev_b32 v13, 16, v120
    v_and_b32 v14, 0xffff0000, v120
    v_fmac_f32 v4, v13, v40
    v_fmac_f32 v5, v14, v40
    v_lshlrev_b32 v13, 16, v121
    v_and_b32 v14, 0xffff0000, v121
    v_fmac_f32 v6, v13, v40
    v_fmac_f32 v7, v14, v40
    v_lshlrev_b32 v13, 16, v122
    v_and_b32 v14, 0xffff0000, v122
    v_fmac_f32 v8, v13, v40
    v_fmac_f32 v9, v14, v40
    v_lshlrev_b32 v13, 16, v123
    v_and_b32 v14, 0xffff0000, v123
    v_fmac_f32 v10, v13, v40
    v_fmac_f32 v11, v14, v40
    s_waitcnt vmcnt(14)
    v_lshlrev_b32 v13, 16, v124
    v_and_b32 v14, 0xffff0000, v124
    v_fmac_f32 v4, v13, v41
    v_fmac_f32 v5, v14, v41
    v_lshlrev_b32 v13, 16, v125
    v_and_b32 v14, 0xffff0000, v125
    v_fmac_f32 v6, v13, v41
    v_fmac_f32 v7, v14, v41
    v_lshlrev_b32 v13, 16, v126
    v_and_b32 v14, 0xffff0000, v126
    v_fmac_f32 v8, v13, v41
    v_fmac_f32 v9, v14, v41
    v_lshlrev_b32 v13, 16, v127
    v_and_b32 v14, 0xffff0000, v127
    v_fmac_f32 v10, v13, v41
    v_fmac_f32 v11, v14, v41
    s_waitcnt vmcnt(13)
    v_lshlrev_b32 v13, 16, v128
    v_and_b32 v14, 0xffff0000, v128
    v_fmac_f32 v4, v13, v42
    v_fmac_f32 v5, v14, v42
    v_lshlrev_b32 v13, 16, v129
    v_and_b32 v14, 0xffff0000, v129
    v_fmac_f32 v6, v13, v42
    v_fmac_f32 v7, v14, v42
    v_lshlrev_b32 v13, 16, v130
    v_and_b32 v14, 0xffff0000, v130
    v_fmac_f32 v8, v13, v42
    v_fmac_f32 v9, v14, v42
    v_lshlrev_b32 v13, 16, v131
    v_and_b32 v14, 0xffff0000, v131
    v_fmac_f32 v10, v13, v42
    v_fmac_f32 v11, v14, v42
    s_waitcnt vmcnt(12)
    v_lshlrev_b32 v13, 16, v132
    v_and_b32 v14, 0xffff0000, v132
    v_fmac_f32 v4, v13, v43
    v_fmac_f32 v5, v14, v43
    v_lshlrev_b32 v13, 16, v133
    v_and_b32 v14, 0xffff0000, v133
    v_fmac_f32 v6, v13, v43
    v_fmac_f32 v7, v14, v43
    v_lshlrev_b32 v13, 16, v134
    v_and_b32 v14, 0xffff0000, v134
    v_fmac_f32 v8, v13, v43
    v_fmac_f32 v9, v14, v43
    v_lshlrev_b32 v13, 16, v135
    v_and_b32 v14, 0xffff0000, v135
    v_fmac_f32 v10, v13, v43
    v_fmac_f32 v11, v14, v43
    s_waitcnt vmcnt(11)
    v_lshlrev_b32 v13, 16, v136
    v_and_b32 v14, 0xffff0000, v136
    v_fmac_f32 v4, v13, v56
    v_fmac_f32 v5, v14, v56
    v_lshlrev_b32 v13, 16, v137
    v_and_b32 v14, 0xffff0000, v137
    v_fmac_f32 v6, v13, v56
    v_fmac_f32 v7, v14, v56
    v_lshlrev_b32 v13, 16, v138
    v_and_b32 v14, 0xffff0000, v138
    v_fmac_f32 v8, v13, v56
    v_fmac_f32 v9, v14, v56
    v_lshlrev_b32 v13, 16, v139
    v_and_b32 v14, 0xffff0000, v139
    v_fmac_f32 v10, v13, v56
    v_fmac_f32 v11, v14, v56
    s_waitcnt vmcnt(10)
    v_lshlrev_b32 v13, 16, v140
    v_and_b32 v14, 0xffff0000, v140
    v_fmac_f32 v4, v13, v57
    v_fmac_f32 v5, v14, v57
    v_lshlrev_b32 v13, 16, v141
    v_and_b32 v14, 0xffff0000, v141
    v_fmac_f32 v6, v13, v57
    v_fmac_f32 v7, v14, v57
    v_lshlrev_b32 v13, 16, v142
    v_and_b32 v14, 0xffff0000, v142
    v_fmac_f32 v8, v13, v57
    v_fmac_f32 v9, v14, v57
    v_lshlrev_b32 v13, 16, v143
    v_and_b32 v14, 0xffff0000, v143
    v_fmac_f32 v10, v13, v57
    v_fmac_f32 v11, v14, v57
    s_waitcnt vmcnt(9)
    v_lshlrev_b32 v13, 16, v144
    v_and_b32 v14, 0xffff0000, v144
    v_fmac_f32 v4, v13, v58
    v_fmac_f32 v5, v14, v58
    v_lshlrev_b32 v13, 16, v145
    v_and_b32 v14, 0xffff0000, v145
    v_fmac_f32 v6, v13, v58
    v_fmac_f32 v7, v14, v58
    v_lshlrev_b32 v13, 16, v146
    v_and_b32 v14, 0xffff0000, v146
    v_fmac_f32 v8, v13, v58
    v_fmac_f32 v9, v14, v58
    v_lshlrev_b32 v13, 16, v147
    v_and_b32 v14, 0xffff0000, v147
    v_fmac_f32 v10, v13, v58
    v_fmac_f32 v11, v14, v58
    s_waitcnt vmcnt(8)
    v_lshlrev_b32 v13, 16, v148
    v_and_b32 v14, 0xffff0000, v148
    v_fmac_f32 v4, v13, v59
    v_fmac_f32 v5, v14, v59
    v_lshlrev_b32 v13, 16, v149
    v_and_b32 v14, 0xffff0000, v149
    v_fmac_f32 v6, v13, v59
    v_fmac_f32 v7, v14, v59
    v_lshlrev_b32 v13, 16, v150
    v_and_b32 v14, 0xffff0000, v150
    v_fmac_f32 v8, v13, v59
    v_fmac_f32 v9, v14, v59
    v_lshlrev_b32 v13, 16, v151
    v_and_b32 v14, 0xffff0000, v151
    v_fmac_f32 v10, v13, v59
    v_fmac_f32 v11, v14, v59
    s_waitcnt vmcnt(7)
    v_lshlrev_b32 v13, 16, v152
    v_and_b32 v14, 0xffff0000, v152
    v_fmac_f32 v4, v13, v72
    v_fmac_f32 v5, v14, v72
    v_lshlrev_b32 v13, 16, v153
    v_and_b32 v14, 0xffff0000, v153
    v_fmac_f32 v6, v13, v72
    v_fmac_f32 v7, v14, v72
    v_lshlrev_b32 v13, 16, v154
    v_and_b32 v14, 0xffff0000, v154
    v_fmac_f32 v8, v13, v72
    v_fmac_f32 v9, v14, v72
    v_lshlrev_b32 v13, 16, v155
    v_and_b32 v14, 0xffff0000, v155
    v_fmac_f32 v10, v13, v72
    v_fmac_f32 v11, v14, v72
    s_waitcnt vmcnt(6)
    v_lshlrev_b32 v13, 16, v156
    v_and_b32 v14, 0xffff0000, v156
    v_fmac_f32 v4, v13, v73
    v_fmac_f32 v5, v14, v73
    v_lshlrev_b32 v13, 16, v157
    v_and_b32 v14, 0xffff0000, v157
    v_fmac_f32 v6, v13, v73
    v_fmac_f32 v7, v14, v73
    v_lshlrev_b32 v13, 16, v158
    v_and_b32 v14, 0xffff0000, v158
    v_fmac_f32 v8, v13, v73
    v_fmac_f32 v9, v14, v73
    v_lshlrev_b32 v13, 16, v159
    v_and_b32 v14, 0xffff0000, v159
    v_fmac_f32 v10, v13, v73
    v_fmac_f32 v11, v14, v73
    s_waitcnt vmcnt(5)
    v_lshlrev_b32 v13, 16, v160
    v_and_b32 v14, 0xffff0000, v160
    v_fmac_f32 v4, v13, v74
    v_fmac_f32 v5, v14, v74
    v_lshlrev_b32 v13, 16, v161
    v_and_b32 v14, 0xffff0000, v161
    v_fmac_f32 v6, v13, v74
    v_fmac_f32 v7, v14, v74
    v_lshlrev_b32 v13, 16, v162
    v_and_b32 v14, 0xffff0000, v162
    v_fmac_f32 v8, v13, v74
    v_fmac_f32 v9, v14, v74
    v_lshlrev_b32 v13, 16, v163
    v_and_b32 v14, 0xffff0000, v163
    v_fmac_f32 v10, v13, v74
    v_fmac_f32 v11, v14, v74
    s_waitcnt vmcnt(4)
    v_lshlrev_b32 v13, 16, v164
    v_and_b32 v14, 0xffff0000, v164
    v_fmac_f32 v4, v13, v75
    v_fmac_f32 v5, v14, v75
    v_lshlrev_b32 v13, 16, v165
    v_and_b32 v14, 0xffff0000, v165
    v_fmac_f32 v6, v13, v75
    v_fmac_f32 v7, v14, v75
    v_lshlrev_b32 v13, 16, v166
    v_and_b32 v14, 0xffff0000, v166
    v_fmac_f32 v8, v13, v75
    v_fmac_f32 v9, v14, v75
    v_lshlrev_b32 v13, 16, v167
    v_and_b32 v14, 0xffff0000, v167
    v_fmac_f32 v10, v13, v75
    v_fmac_f32 v11, v14, v75
    s_nop 1
    v_permlane32_swap_b32 v4, v8
    v_permlane32_swap_b32 v5, v9
    v_permlane32_swap_b32 v6, v10
    v_permlane32_swap_b32 v7, v11
    v_add_f32 v4, v4, v8
    v_add_f32 v5, v5, v9
    v_add_f32 v6, v6, v10
    v_add_f32 v7, v7, v11
    s_nop 1
    v_permlane16_swap_b32 v4, v6
    v_permlane16_swap_b32 v5, v7
    v_add_f32 v4, v4, v6
    v_add_f32 v5, v5, v7
    v_add_u32 v12, s9, v3
    ds_write_b64 v12, v[4:5] offset:1024
    s_waitcnt lgkmcnt(0)
    s_barrier
    s_waitcnt vmcnt(0)
    v_lshlrev_b32 v104, 16, v88
    v_and_b32 v105, 0xffff0000, v88
    v_lshlrev_b32 v106, 16, v89
    v_and_b32 v107, 0xffff0000, v89
    v_lshlrev_b32 v108, 16, v90
    v_and_b32 v109, 0xffff0000, v90
    v_lshlrev_b32 v110, 16, v91
    v_and_b32 v111, 0xffff0000, v91
    v_lshlrev_b32 v112, 16, v92
    v_and_b32 v113, 0xffff0000, v92
    v_lshlrev_b32 v114, 16, v93
    v_and_b32 v115, 0xffff0000, v93
    v_lshlrev_b32 v116, 16, v94
    v_and_b32 v117, 0xffff0000, v94
    v_lshlrev_b32 v118, 16, v95
    v_and_b32 v119, 0xffff0000, v95
    v_lshlrev_b32 v120, 16, v96
    v_and_b32 v121, 0xffff0000, v96
    v_lshlrev_b32 v122, 16, v97
    v_and_b32 v123, 0xffff0000, v97
    v_lshlrev_b32 v124, 16, v98
    v_and_b32 v125, 0xffff0000, v98
    v_lshlrev_b32 v126, 16, v99
    v_and_b32 v127, 0xffff0000, v99
    v_lshlrev_b32 v128, 16, v100
    v_and_b32 v129, 0xffff0000, v100
    v_lshlrev_b32 v130, 16, v101
    v_and_b32 v131, 0xffff0000, v101
    v_lshlrev_b32 v132, 16, v102
    v_and_b32 v133, 0xffff0000, v102
    v_lshlrev_b32 v134, 16, v103
    v_and_b32 v135, 0xffff0000, v103
    s_lshl_b32 s7, s5, 6
    v_lshrrev_b32 v12, 4, v0
    v_lshlrev_b32 v12, 4, v12
    v_add_u32 v12, s7, v12
    s_barrier
    ds_read_b128 v[24:27], v12 offset:10240
    s_waitcnt lgkmcnt(0)
    v_mul_f32 v4, v104, v24
    v_mul_f32 v5, v105, v24
    v_mul_f32 v6, v106, v24
    v_mul_f32 v7, v107, v24
    v_mul_f32 v8, v108, v24
    v_mul_f32 v9, v109, v24
    v_mul_f32 v10, v110, v24
    v_mul_f32 v11, v111, v24
    v_fmac_f32 v4, v112, v25
    v_fmac_f32 v5, v113, v25
    v_fmac_f32 v6, v114, v25
    v_fmac_f32 v7, v115, v25
    v_fmac_f32 v8, v116, v25
    v_fmac_f32 v9, v117, v25
    v_fmac_f32 v10, v118, v25
    v_fmac_f32 v11, v119, v25
    v_fmac_f32 v4, v120, v26
    v_fmac_f32 v5, v121, v26
    v_fmac_f32 v6, v122, v26
    v_fmac_f32 v7, v123, v26
    v_fmac_f32 v8, v124, v26
    v_fmac_f32 v9, v125, v26
    v_fmac_f32 v10, v126, v26
    v_fmac_f32 v11, v127, v26
    v_fmac_f32 v4, v128, v27
    v_fmac_f32 v5, v129, v27
    v_fmac_f32 v6, v130, v27
    v_fmac_f32 v7, v131, v27
    v_fmac_f32 v8, v132, v27
    v_fmac_f32 v9, v133, v27
    v_fmac_f32 v10, v134, v27
    v_fmac_f32 v11, v135, v27
    s_nop 1
    v_permlane32_swap_b32 v4, v8
    v_permlane32_swap_b32 v5, v9
    v_permlane32_swap_b32 v6, v10
    v_permlane32_swap_b32 v7, v11
    v_add_f32 v4, v4, v8
    v_add_f32 v5, v5, v9
    v_add_f32 v6, v6, v10
    v_add_f32 v7, v7, v11
    s_nop 1
    v_permlane16_swap_b32 v4, v6
    v_permlane16_swap_b32 v5, v7
    v_add_f32 v4, v4, v6
    v_add_f32 v5, v5, v7
    s_lshl_b32 s6, s5, 9
    v_add_u32 v12, s6, v3
    ds_write_b64 v12, v[4:5] offset:5632
    s_waitcnt lgkmcnt(0)
    s_barrier
    s_branch L_end
L_sync:
    s_memrealtime s[64:65]
    v_and_b32 v1, 15, v0
    v_lshrrev_b32 v2, 4, v0
    s_waitcnt lgkmcnt(0)
    s_mov_b32 s56, s28
    s_and_b32 s57, s29, 0xffff
    s_mov_b32 s58, 0x100
    s_mov_b32 s59, 0x00020000
    s_or_b32 s64, s64, 1
    s_or_b32 s65, s65, 1
    v_mov_b32 v144, s64
    v_mov_b32 v145, s65
    v_mov_b32 v146, 0
    v_mov_b32 v147, 0
    s_lshl_b32 s6, s3, 3
    v_mov_b32 v3, s6
    s_mov_b64 exec, 1
    buffer_atomic_cmpswap_x2 v[144:147], v3, s[56:59], 0 offen sc0 sc1
    s_mov_b64 exec, -1
    s_mul_i32 s7, s4, 160
    s_add_u32 s32, s16, s7
    s_addc_u32 s33, s17, 0
    s_and_b32 s33, s33, 0xffff
    s_mov_b32 s34, 0xa0
    s_mov_b32 s35, 0x00020000
    s_mul_i32 s7, s4, 0xa0000
    s_lshl_b32 s8, s3, 8
    s_add_u32 s7, s7, s8
    s_sub_u32 s8, 0xa0000, s8
    s_add_u32 s44, s22, s7
    s_addc_u32 s45, s23, 0
    s_and_b32 s45, s45, 0xffff
    s_mov_b32 s46, s8
    s_mov_b32 s47, 0x00020000
    v_mul_u32_u24 v12, 40, v2
    buffer_load_dwordx4 v[16:19], v12, s[32:35], 0 offen
    buffer_load_dwordx4 v[20:23], v12, s[32:35], 0 offen offset:16
    buffer_load_dwordx2 v[24:25], v12, s[32:35], 0 offen offset:32
    v_mul_u32_u24 v13, 20, v2
    v_lshlrev_b32 v13, 13, v13
    v_lshl_add_u32 v13, v1, 4, v13
    s_mov_b32 s70, 0
    buffer_load_dwordx4 v[32:35], v13, s[44:47], s70 offen nt
    s_add_u32 s70, s70, 0x2000
    buffer_load_dwordx4 v[36:39], v13, s[44:47], s70 offen nt
    s_add_u32 s70, s70, 0x2000
    buffer_load_dwordx4 v[40:43], v13, s[44:47], s70 offen nt
    s_add_u32 s70, s70, 0x2000
    buffer_load_dwordx4 v[44:47], v13, s[44:47], s70 offen nt
    s_add_u32 s70, s70, 0x2000
    buffer_load_dwordx4 v[48:51], v13, s[44:47], s70 offen nt
    s_add_u32 s70, s70, 0x2000
    buffer_load_dwordx4 v[52:55], v13, s[44:47], s70 offen nt
    s_add_u32 s70, s70, 0x2000
    buffer_load_dwordx4 v[56:59], v13, s[44:47], s70 offen nt
    s_add_u32 s70, s70, 0x2000
    buffer_load_dwordx4 v[60:63], v13, s[44:47], s70 offen nt
    s_add_u32 s70, s70, 0x2000
    buffer_load_dwordx4 v[64:67], v13, s[44:47], s70 offen nt
    s_add_u32 s70, s70, 0x2000
    buffer_load_dwordx4 v[68:71], v13, s[44:47], s70 offen nt
    s_add_u32 s70, s70, 0x2000
    buffer_load_dwordx4 v[72:75], v13, s[44:47], s70 offen nt
    s_add_u32 s70, s70, 0x2000
    buffer_load_dwordx4 v[76:79], v13, s[44:47], s70 offen nt
    s_add_u32 s70, s70, 0x2000
    buffer_load_dwordx4 v[80:83], v13, s[44:47], s70 offen nt
    s_add_u32 s70, s70, 0x2000
    buffer_load_dwordx4 v[84:87], v13, s[44:47], s70 offen nt
    s_add_u32 s70, s70, 0x2000
    buffer_load_dwordx4 v[88:91], v13, s[44:47], s70 offen nt
    s_add_u32 s70, s70, 0x2000
    buffer_load_dwordx4 v[92:95], v13, s[44:47], s70 offen nt
    s_add_u32 s70, s70, 0x2000
    buffer_load_dwordx4 v[96:99], v13, s[44:47], s70 offen nt
    s_add_u32 s70, s70, 0x2000
    buffer_load_dwordx4 v[100:103], v13, s[44:47], s70 offen nt
    s_add_u32 s70, s70, 0x2000
    buffer_load_dwordx4 v[104:107], v13, s[44:47], s70 offen nt
    s_add_u32 s70, s70, 0x2000
    buffer_load_dwordx4 v[108:111], v13, s[44:47], s70 offen nt
    s_add_u32 s70, s70, 0x2000
    s_barrier
    s_mov_b32 s60, s30
    s_and_b32 s61, s31, 0xffff
    s_mov_b32 s62, 0x400000
    s_mov_b32 s63, 0x00020000
    s_mov_b32 s52, s26
    s_and_b32 s53, s27, 0xffff
    s_mov_b32 s54, 0x500
    s_mov_b32 s55, 0x00020000
    v_lshlrev_b32 v27, 6, v1
    v_lshl_add_u32 v27, v2, 4, v27
    s_lshl_b32 s6, s3, 13
    s_add_u32 s6, s6, 0x80000
    v_add_u32 v27, s6, v27
    s_lshl_b32 s7, s4, 10
    v_add_u32 v26, s7, v27
    s_waitcnt vmcnt(23)
    v_readfirstlane_b32 s66, v144
    v_readfirstlane_b32 s67, v145
    s_nop 3
    s_or_b32 s6, s66, s67
    s_cmp_eq_u32 s6, 0
    s_cselect_b32 s66, s64, s66
    s_cselect_b32 s67, s65, s67
    v_mov_b32 v149, s66
    v_mov_b32 v151, s67
    s_waitcnt vmcnt(19)
    v_lshlrev_b32 v12, 16, v16
    v_lshlrev_b32 v13, 16, v32
    v_and_b32 v14, 0xffff0000, v32
    v_mul_f32 v4, v13, v12
    v_mul_f32 v5, v14, v12
    v_lshlrev_b32 v13, 16, v33
    v_and_b32 v14, 0xffff0000, v33
    v_mul_f32 v6, v13, v12
    v_mul_f32 v7, v14, v12
    v_lshlrev_b32 v13, 16, v34
    v_and_b32 v14, 0xffff0000, v34
    v_mul_f32 v8, v13, v12
    v_mul_f32 v9, v14, v12
    v_lshlrev_b32 v13, 16, v35
    v_and_b32 v14, 0xffff0000, v35
    v_mul_f32 v10, v13, v12
    v_mul_f32 v11, v14, v12
    s_waitcnt vmcnt(18)
    v_and_b32 v12, 0xffff0000, v16
    v_lshlrev_b32 v13, 16, v36
    v_and_b32 v14, 0xffff0000, v36
    v_fmac_f32 v4, v13, v12
    v_fmac_f32 v5, v14, v12
    v_lshlrev_b32 v13, 16, v37
    v_and_b32 v14, 0xffff0000, v37
    v_fmac_f32 v6, v13, v12
    v_fmac_f32 v7, v14, v12
    v_lshlrev_b32 v13, 16, v38
    v_and_b32 v14, 0xffff0000, v38
    v_fmac_f32 v8, v13, v12
    v_fmac_f32 v9, v14, v12
    v_lshlrev_b32 v13, 16, v39
    v_and_b32 v14, 0xffff0000, v39
    v_fmac_f32 v10, v13, v12
    v_fmac_f32 v11, v14, v12
    s_waitcnt vmcnt(17)
    v_lshlrev_b32 v12, 16, v17
    v_lshlrev_b32 v13, 16, v40
    v_and_b32 v14, 0xffff0000, v40
    v_fmac_f32 v4, v13, v12
    v_fmac_f32 v5, v14, v12
    v_lshlrev_b32 v13, 16, v41
    v_and_b32 v14, 0xffff0000, v41
    v_fmac_f32 v6, v13, v12
    v_fmac_f32 v7, v14, v12
    v_lshlrev_b32 v13, 16, v42
    v_and_b32 v14, 0xffff0000, v42
    v_fmac_f32 v8, v13, v12
    v_fmac_f32 v9, v14, v12
    v_lshlrev_b32 v13, 16, v43
    v_and_b32 v14, 0xffff0000, v43
    v_fmac_f32 v10, v13, v12
    v_fmac_f32 v11, v14, v12
    s_waitcnt vmcnt(16)
    v_and_b32 v12, 0xffff0000, v17
    v_lshlrev_b32 v13, 16, v44
    v_and_b32 v14, 0xffff0000, v44
    v_fmac_f32 v4, v13, v12
    v_fmac_f32 v5, v14, v12
    v_lshlrev_b32 v13, 16, v45
    v_and_b32 v14, 0xffff0000, v45
    v_fmac_f32 v6, v13, v12
    v_fmac_f32 v7, v14, v12
    v_lshlrev_b32 v13, 16, v46
    v_and_b32 v14, 0xffff0000, v46
    v_fmac_f32 v8, v13, v12
    v_fmac_f32 v9, v14, v12
    v_lshlrev_b32 v13, 16, v47
    v_and_b32 v14, 0xffff0000, v47
    v_fmac_f32 v10, v13, v12
    v_fmac_f32 v11, v14, v12
    s_waitcnt vmcnt(15)
    v_lshlrev_b32 v12, 16, v18
    v_lshlrev_b32 v13, 16, v48
    v_and_b32 v14, 0xffff0000, v48
    v_fmac_f32 v4, v13, v12
    v_fmac_f32 v5, v14, v12
    v_lshlrev_b32 v13, 16, v49
    v_and_b32 v14, 0xffff0000, v49
    v_fmac_f32 v6, v13, v12
    v_fmac_f32 v7, v14, v12
    v_lshlrev_b32 v13, 16, v50
    v_and_b32 v14, 0xffff0000, v50
    v_fmac_f32 v8, v13, v12
    v_fmac_f32 v9, v14, v12
    v_lshlrev_b32 v13, 16, v51
    v_and_b32 v14, 0xffff0000, v51
    v_fmac_f32 v10, v13, v12
    v_fmac_f32 v11, v14, v12
    s_waitcnt vmcnt(14)
    v_and_b32 v12, 0xffff0000, v18
    v_lshlrev_b32 v13, 16, v52
    v_and_b32 v14, 0xffff0000, v52
    v_fmac_f32 v4, v13, v12
    v_fmac_f32 v5, v14, v12
    v_lshlrev_b32 v13, 16, v53
    v_and_b32 v14, 0xffff0000, v53
    v_fmac_f32 v6, v13, v12
    v_fmac_f32 v7, v14, v12
    v_lshlrev_b32 v13, 16, v54
    v_and_b32 v14, 0xffff0000, v54
    v_fmac_f32 v8, v13, v12
    v_fmac_f32 v9, v14, v12
    v_lshlrev_b32 v13, 16, v55
    v_and_b32 v14, 0xffff0000, v55
    v_fmac_f32 v10, v13, v12
    v_fmac_f32 v11, v14, v12
    s_waitcnt vmcnt(13)
    v_lshlrev_b32 v12, 16, v19
    v_lshlrev_b32 v13, 16, v56
    v_and_b32 v14, 0xffff0000, v56
    v_fmac_f32 v4, v13, v12
    v_fmac_f32 v5, v14, v12
    v_lshlrev_b32 v13, 16, v57
    v_and_b32 v14, 0xffff0000, v57
    v_fmac_f32 v6, v13, v12
    v_fmac_f32 v7, v14, v12
    v_lshlrev_b32 v13, 16, v58
    v_and_b32 v14, 0xffff0000, v58
    v_fmac_f32 v8, v13, v12
    v_fmac_f32 v9, v14, v12
    v_lshlrev_b32 v13, 16, v59
    v_and_b32 v14, 0xffff0000, v59
    v_fmac_f32 v10, v13, v12
    v_fmac_f32 v11, v14, v12
    s_waitcnt vmcnt(12)
    v_and_b32 v12, 0xffff0000, v19
    v_lshlrev_b32 v13, 16, v60
    v_and_b32 v14, 0xffff0000, v60
    v_fmac_f32 v4, v13, v12
    v_fmac_f32 v5, v14, v12
    v_lshlrev_b32 v13, 16, v61
    v_and_b32 v14, 0xffff0000, v61
    v_fmac_f32 v6, v13, v12
    v_fmac_f32 v7, v14, v12
    v_lshlrev_b32 v13, 16, v62
    v_and_b32 v14, 0xffff0000, v62
    v_fmac_f32 v8, v13, v12
    v_fmac_f32 v9, v14, v12
    v_lshlrev_b32 v13, 16, v63
    v_and_b32 v14, 0xffff0000, v63
    v_fmac_f32 v10, v13, v12
    v_fmac_f32 v11, v14, v12
    s_waitcnt vmcnt(11)
    v_lshlrev_b32 v12, 16, v20
    v_lshlrev_b32 v13, 16, v64
    v_and_b32 v14, 0xffff0000, v64
    v_fmac_f32 v4, v13, v12
    v_fmac_f32 v5, v14, v12
    v_lshlrev_b32 v13, 16, v65
    v_and_b32 v14, 0xffff0000, v65
    v_fmac_f32 v6, v13, v12
    v_fmac_f32 v7, v14, v12
    v_lshlrev_b32 v13, 16, v66
    v_and_b32 v14, 0xffff0000, v66
    v_fmac_f32 v8, v13, v12
    v_fmac_f32 v9, v14, v12
    v_lshlrev_b32 v13, 16, v67
    v_and_b32 v14, 0xffff0000, v67
    v_fmac_f32 v10, v13, v12
    v_fmac_f32 v11, v14, v12
    s_waitcnt vmcnt(10)
    v_and_b32 v12, 0xffff0000, v20
    v_lshlrev_b32 v13, 16, v68
    v_and_b32 v14, 0xffff0000, v68
    v_fmac_f32 v4, v13, v12
    v_fmac_f32 v5, v14, v12
    v_lshlrev_b32 v13, 16, v69
    v_and_b32 v14, 0xffff0000, v69
    v_fmac_f32 v6, v13, v12
    v_fmac_f32 v7, v14, v12
    v_lshlrev_b32 v13, 16, v70
    v_and_b32 v14, 0xffff0000, v70
    v_fmac_f32 v8, v13, v12
    v_fmac_f32 v9, v14, v12
    v_lshlrev_b32 v13, 16, v71
    v_and_b32 v14, 0xffff0000, v71
    v_fmac_f32 v10, v13, v12
    v_fmac_f32 v11, v14, v12
    s_waitcnt vmcnt(9)
    v_lshlrev_b32 v12, 16, v21
    v_lshlrev_b32 v13, 16, v72
    v_and_b32 v14, 0xffff0000, v72
    v_fmac_f32 v4, v13, v12
    v_fmac_f32 v5, v14, v12
    v_lshlrev_b32 v13, 16, v73
    v_and_b32 v14, 0xffff0000, v73
    v_fmac_f32 v6, v13, v12
    v_fmac_f32 v7, v14, v12
    v_lshlrev_b32 v13, 16, v74
    v_and_b32 v14, 0xffff0000, v74
    v_fmac_f32 v8, v13, v12
    v_fmac_f32 v9, v14, v12
    v_lshlrev_b32 v13, 16, v75
    v_and_b32 v14, 0xffff0000, v75
    v_fmac_f32 v10, v13, v12
    v_fmac_f32 v11, v14, v12
    s_waitcnt vmcnt(8)
    v_and_b32 v12, 0xffff0000, v21
    v_lshlrev_b32 v13, 16, v76
    v_and_b32 v14, 0xffff0000, v76
    v_fmac_f32 v4, v13, v12
    v_fmac_f32 v5, v14, v12
    v_lshlrev_b32 v13, 16, v77
    v_and_b32 v14, 0xffff0000, v77
    v_fmac_f32 v6, v13, v12
    v_fmac_f32 v7, v14, v12
    v_lshlrev_b32 v13, 16, v78
    v_and_b32 v14, 0xffff0000, v78
    v_fmac_f32 v8, v13, v12
    v_fmac_f32 v9, v14, v12
    v_lshlrev_b32 v13, 16, v79
    v_and_b32 v14, 0xffff0000, v79
    v_fmac_f32 v10, v13, v12
    v_fmac_f32 v11, v14, v12
    s_waitcnt vmcnt(7)
    v_lshlrev_b32 v12, 16, v22
    v_lshlrev_b32 v13, 16, v80
    v_and_b32 v14, 0xffff0000, v80
    v_fmac_f32 v4, v13, v12
    v_fmac_f32 v5, v14, v12
    v_lshlrev_b32 v13, 16, v81
    v_and_b32 v14, 0xffff0000, v81
    v_fmac_f32 v6, v13, v12
    v_fmac_f32 v7, v14, v12
    v_lshlrev_b32 v13, 16, v82
    v_and_b32 v14, 0xffff0000, v82
    v_fmac_f32 v8, v13, v12
    v_fmac_f32 v9, v14, v12
    v_lshlrev_b32 v13, 16, v83
    v_and_b32 v14, 0xffff0000, v83
    v_fmac_f32 v10, v13, v12
    v_fmac_f32 v11, v14, v12
    s_waitcnt vmcnt(6)
    v_and_b32 v12, 0xffff0000, v22
    v_lshlrev_b32 v13, 16, v84
    v_and_b32 v14, 0xffff0000, v84
    v_fmac_f32 v4, v13, v12
    v_fmac_f32 v5, v14, v12
    v_lshlrev_b32 v13, 16, v85
    v_and_b32 v14, 0xffff0000, v85
    v_fmac_f32 v6, v13, v12
    v_fmac_f32 v7, v14, v12
    v_lshlrev_b32 v13, 16, v86
    v_and_b32 v14, 0xffff0000, v86
    v_fmac_f32 v8, v13, v12
    v_fmac_f32 v9, v14, v12
    v_lshlrev_b32 v13, 16, v87
    v_and_b32 v14, 0xffff0000, v87
    v_fmac_f32 v10, v13, v12
    v_fmac_f32 v11, v14, v12
    s_waitcnt vmcnt(5)
    v_lshlrev_b32 v12, 16, v23
    v_lshlrev_b32 v13, 16, v88
    v_and_b32 v14, 0xffff0000, v88
    v_fmac_f32 v4, v13, v12
    v_fmac_f32 v5, v14, v12
    v_lshlrev_b32 v13, 16, v89
    v_and_b32 v14, 0xffff0000, v89
    v_fmac_f32 v6, v13, v12
    v_fmac_f32 v7, v14, v12
    v_lshlrev_b32 v13, 16, v90
    v_and_b32 v14, 0xffff0000, v90
    v_fmac_f32 v8, v13, v12
    v_fmac_f32 v9, v14, v12
    v_lshlrev_b32 v13, 16, v91
    v_and_b32 v14, 0xffff0000, v91
    v_fmac_f32 v10, v13, v12
    v_fmac_f32 v11, v14, v12
    s_waitcnt vmcnt(4)
    v_and_b32 v12, 0xffff0000, v23
    v_lshlrev_b32 v13, 16, v92
    v_and_b32 v14, 0xffff0000, v92
    v_fmac_f32 v4, v13, v12
    v_fmac_f32 v5, v14, v12
    v_lshlrev_b32 v13, 16, v93
    v_and_b32 v14, 0xffff0000, v93
    v_fmac_f32 v6, v13, v12
    v_fmac_f32 v7, v14, v12
    v_lshlrev_b32 v13, 16, v94
    v_and_b32 v14, 0xffff0000, v94
    v_fmac_f32 v8, v13, v12
    v_fmac_f32 v9, v14, v12
    v_lshlrev_b32 v13, 16, v95
    v_and_b32 v14, 0xffff0000, v95
    v_fmac_f32 v10, v13, v12
    v_fmac_f32 v11, v14, v12
    s_waitcnt vmcnt(3)
    v_lshlrev_b32 v12, 16, v24
    v_lshlrev_b32 v13, 16, v96
    v_and_b32 v14, 0xffff0000, v96
    v_fmac_f32 v4, v13, v12
    v_fmac_f32 v5, v14, v12
    v_lshlrev_b32 v13, 16, v97
    v_and_b32 v14, 0xffff0000, v97
    v_fmac_f32 v6, v13, v12
    v_fmac_f32 v7, v14, v12
    v_lshlrev_b32 v13, 16, v98
    v_and_b32 v14, 0xffff0000, v98
    v_fmac_f32 v8, v13, v12
    v_fmac_f32 v9, v14, v12
    v_lshlrev_b32 v13, 16, v99
    v_and_b32 v14, 0xffff0000, v99
    v_fmac_f32 v10, v13, v12
    v_fmac_f32 v11, v14, v12
    s_waitcnt vmcnt(2)
    v_and_b32 v12, 0xffff0000, v24
    v_lshlrev_b32 v13, 16, v100
    v_and_b32 v14, 0xffff0000, v100
    v_fmac_f32 v4, v13, v12
    v_fmac_f32 v5, v14, v12
    v_lshlrev_b32 v13, 16, v101
    v_and_b32 v14, 0xffff0000, v101
    v_fmac_f32 v6, v13, v12
    v_fmac_f32 v7, v14, v12
    v_lshlrev_b32 v13, 16, v102
    v_and_b32 v14, 0xffff0000, v102
    v_fmac_f32 v8, v13, v12
    v_fmac_f32 v9, v14, v12
    v_lshlrev_b32 v13, 16, v103
    v_and_b32 v14, 0xffff0000, v103
    v_fmac_f32 v10, v13, v12
    v_fmac_f32 v11, v14, v12
    s_waitcnt vmcnt(1)
    v_lshlrev_b32 v12, 16, v25
    v_lshlrev_b32 v13, 16, v104
    v_and_b32 v14, 0xffff0000, v104
    v_fmac_f32 v4, v13, v12
    v_fmac_f32 v5, v14, v12
    v_lshlrev_b32 v13, 16, v105
    v_and_b32 v14, 0xffff0000, v105
    v_fmac_f32 v6, v13, v12
    v_fmac_f32 v7, v14, v12
    v_lshlrev_b32 v13, 16, v106
    v_and_b32 v14, 0xffff0000, v106
    v_fmac_f32 v8, v13, v12
    v_fmac_f32 v9, v14, v12
    v_lshlrev_b32 v13, 16, v107
    v_and_b32 v14, 0xffff0000, v107
    v_fmac_f32 v10, v13, v12
    v_fmac_f32 v11, v14, v12
    s_waitcnt vmcnt(0)
    v_and_b32 v12, 0xffff0000, v25
    v_lshlrev_b32 v13, 16, v108
    v_and_b32 v14, 0xffff0000, v108
    v_fmac_f32 v4, v13, v12
    v_fmac_f32 v5, v14, v12
    v_lshlrev_b32 v13, 16, v109
    v_and_b32 v14, 0xffff0000, v109
    v_fmac_f32 v6, v13, v12
    v_fmac_f32 v7, v14, v12
    v_lshlrev_b32 v13, 16, v110
    v_and_b32 v14, 0xffff0000, v110
    v_fmac_f32 v8, v13, v12
    v_fmac_f32 v9, v14, v12
    v_lshlrev_b32 v13, 16, v111
    v_and_b32 v14, 0xffff0000, v111
    v_fmac_f32 v10, v13, v12
    v_fmac_f32 v11, v14, v12
    s_nop 1
    v_permlane32_swap_b32 v4, v8
    v_permlane32_swap_b32 v5, v9
    v_permlane32_swap_b32 v6, v10
    v_permlane32_swap_b32 v7, v11
    v_add_f32 v4, v4, v8
    v_add_f32 v5, v5, v9
    v_add_f32 v6, v6, v10
    v_add_f32 v7, v7, v11
    s_nop 1
    v_permlane16_swap_b32 v4, v6
    v_permlane16_swap_b32 v5, v7
    v_add_f32 v4, v4, v6
    v_add_f32 v5, v5, v7
    v_mov_b32 v148, v4
    v_mov_b32 v150, v5
    buffer_store_dwordx4 v[148:151], v26, s[60:63], 0 offen sc1
    s_barrier
    s_movk_i32 s6, 0x1000
    s_mov_b32 s76, 0
    buffer_load_dwordx4 v[112:115], v27, s[60:63], 0 offen offset:0 sc1
    buffer_load_dwordx4 v[116:119], v27, s[60:63], 0 offen offset:1024 sc1
    buffer_load_dwordx4 v[120:123], v27, s[60:63], 0 offen offset:2048 sc1
    buffer_load_dwordx4 v[124:127], v27, s[60:63], 0 offen offset:3072 sc1
    buffer_load_dwordx4 v[128:131], v27, s[60:63], s6 offen offset:0 sc1
    buffer_load_dwordx4 v[132:135], v27, s[60:63], s6 offen offset:1024 sc1
    buffer_load_dwordx4 v[136:139], v27, s[60:63], s6 offen offset:2048 sc1
    buffer_load_dwordx4 v[140:143], v27, s[60:63], s6 offen offset:3072 sc1
    s_barrier
L_gchk:
    s_waitcnt vmcnt(0)
L_gchk2:
    v_xor_b32 v15, s66, v113
    v_xor_b32 v13, s67, v115
    v_or_b32 v14, v15, v13
    v_xor_b32 v15, s66, v117
    v_xor_b32 v13, s67, v119
    v_or3_b32 v14, v14, v15, v13
    v_xor_b32 v15, s66, v121
    v_xor_b32 v13, s67, v123
    v_or3_b32 v14, v14, v15, v13
    v_xor_b32 v15, s66, v125
    v_xor_b32 v13, s67, v127
    v_or3_b32 v14, v14, v15, v13
    v_xor_b32 v15, s66, v129
    v_xor_b32 v13, s67, v131
    v_or3_b32 v14, v14, v15, v13
    v_xor_b32 v15, s66, v133
    v_xor_b32 v13, s67, v135
    v_or3_b32 v14, v14, v15, v13
    v_xor_b32 v15, s66, v137
    v_xor_b32 v13, s67, v139
    v_or3_b32 v14, v14, v15, v13
    v_xor_b32 v15, s66, v141
    v_xor_b32 v13, s67, v143
    v_or3_b32 v14, v14, v15, v13
    v_cmp_ne_u32 vcc, 0, v14
    s_nop 1
    s_cbranch_vccz L_gok
    s_add_u32 s76, s76, 1
    s_cmp_gt_u32 s76, 0x40000
    s_cbranch_scc1 L_gok
    buffer_load_dwordx4 v[112:115], v27, s[60:63], 0 offen offset:0 sc1
    buffer_load_dwordx4 v[116:119], v27, s[60:63], 0 offen offset:1024 sc1
    buffer_load_dwordx4 v[120:123], v27, s[60:63], 0 offen offset:2048 sc1
    buffer_load_dwordx4 v[124:127], v27, s[60:63], 0 offen offset:3072 sc1
    buffer_load_dwordx4 v[128:131], v27, s[60:63], s6 offen offset:0 sc1
    buffer_load_dwordx4 v[132:135], v27, s[60:63], s6 offen offset:1024 sc1
    buffer_load_dwordx4 v[136:139], v27, s[60:63], s6 offen offset:2048 sc1
    buffer_load_dwordx4 v[140:143], v27, s[60:63], s6 offen offset:3072 sc1
    s_branch L_gchk
L_gok:
    v_add_f32 v112, v112, v116
    v_add_f32 v114, v114, v118
    v_add_f32 v112, v112, v120
    v_add_f32 v114, v114, v122
    v_add_f32 v112, v112, v124
    v_add_f32 v114, v114, v126
    v_add_f32 v112, v112, v128
    v_add_f32 v114, v114, v130
    v_add_f32 v112, v112, v132
    v_add_f32 v114, v114, v134
    v_add_f32 v112, v112, v136
    v_add_f32 v114, v114, v138
    v_add_f32 v112, v112, v140
    v_add_f32 v114, v114, v142
    v_cvt_pk_bf16_f32 v112, v112, v114
    v_lshlrev_b32 v12, 4, v1
    v_lshl_add_u32 v12, v2, 2, v12
    ds_write_b32 v12, v112 offset:0
    v_and_b32 v3, 31, v0
    v_lshlrev_b32 v3, 3, v3
    buffer_load_dwordx2 v[30:31], v3, s[56:59], 0 offen sc1
    s_waitcnt lgkmcnt(0)
    s_barrier
    s_mov_b32 s76, 0
L_flagchk:
    s_waitcnt vmcnt(0)
    v_cmp_eq_u32 vcc, 0, v30
    s_nop 1
    s_cbranch_vccz L_flagok
    s_add_u32 s76, s76, 1
    s_cmp_gt_u32 s76, 0x40000
    s_cbranch_scc1 L_flagok
    buffer_load_dwordx2 v[30:31], v3, s[56:59], 0 offen sc1
    s_branch L_flagchk
L_flagok:
    s_lshl_b32 s6, s3, 14
    s_lshl_b32 s7, s4, 11
    s_add_u32 s6, s6, s7
    v_lshlrev_b32 v12, 4, v0
    v_add_u32 v26, s6, v12
    s_mul_i32 s6, s4, 20480
    s_lshl_b32 s7, s3, 4
    s_add_u32 s6, s6, s7
    s_add_u32 s6, s6, 0xc0000
    v_lshlrev_b32 v27, 9, v0
    v_add_u32 v27, s6, v27
    s_mul_i32 s6, s4, 20
    s_add_u32 s6, s6, s3
    s_lshl_b32 s6, s6, 10
    s_add_u32 s6, s6, 0xc0000
    v_add_u32 v3, s6, v12
    s_lshl_b32 s6, s3, 14
    v_add_u32 v92, s6, v12
    v_and_b32 v29, 7, v0
    v_lshlrev_b32 v29, 11, v29
    s_add_u32 s6, s6, 1024
    v_add_u32 v29, s6, v29
    s_movk_i32 s8, 0x1000
    s_movk_i32 s9, 0x3000
    v_lshlrev_b32 v12, 3, v0
    v_mov_b32 v13, 0
    v_mov_b32 v145, s66
    v_mov_b32 v147, s67
    s_barrier
    ds_read_b64 v[128:129], v13 offset:1536
    ds_read_b64 v[130:131], v13 offset:2064
    ds_read_b64 v[132:133], v13 offset:2592
    ds_read_b64 v[134:135], v13 offset:3120
    ds_read_b64 v[136:137], v13 offset:3648
    ds_read_b64 v[138:139], v13 offset:4176
    ds_read_b64 v[140:141], v13 offset:4704
    ds_read_b64 v[142:143], v13 offset:5232
    ds_read_b64 v[112:113], v12 offset:1024
    ds_read_b64 v[114:115], v12 offset:1552
    ds_read_b64 v[116:117], v12 offset:2080
    ds_read_b64 v[118:119], v12 offset:2608
    s_waitcnt lgkmcnt(4)
    ds_read_b64 v[120:121], v12 offset:3136
    ds_read_b64 v[122:123], v12 offset:3664
    ds_read_b64 v[124:125], v12 offset:4192
    ds_read_b64 v[126:127], v12 offset:4720
    v_max3_f32 v146, v129, v131, v133
    v_max3_f32 v146, v146, v135, v137
    v_max3_f32 v146, v146, v139, v141
    v_max_f32 v146, v146, v143
    v_sub_f32 v129, v129, v146
    v_sub_f32 v131, v131, v146
    v_sub_f32 v133, v133, v146
    v_sub_f32 v135, v135, v146
    v_sub_f32 v137, v137, v146
    v_sub_f32 v139, v139, v146
    v_sub_f32 v141, v141, v146
    v_sub_f32 v143, v143, v146
    v_mul_f32 v129, s75, v129
    v_mul_f32 v131, s75, v131
    v_mul_f32 v133, s75, v133
    v_mul_f32 v135, s75, v135
    v_mul_f32 v137, s75, v137
    v_mul_f32 v139, s75, v139
    v_mul_f32 v141, s75, v141
    v_mul_f32 v143, s75, v143
    v_exp_f32 v129, v129
    v_exp_f32 v131, v131
    v_exp_f32 v133, v133
    v_exp_f32 v135, v135
    v_exp_f32 v137, v137
    v_exp_f32 v139, v139
    v_exp_f32 v141, v141
    v_exp_f32 v143, v143
    s_waitcnt lgkmcnt(0)
    v_mul_f32 v148, v112, v129
    v_mul_f32 v150, v113, v129
    v_fmac_f32 v148, v114, v131
    v_fmac_f32 v150, v115, v131
    v_fmac_f32 v148, v116, v133
    v_fmac_f32 v150, v117, v133
    v_fmac_f32 v148, v118, v135
    v_fmac_f32 v150, v119, v135
    v_fmac_f32 v148, v120, v137
    v_fmac_f32 v150, v121, v137
    v_fmac_f32 v148, v122, v139
    v_fmac_f32 v150, v123, v139
    v_fmac_f32 v148, v124, v141
    v_fmac_f32 v150, v125, v141
    v_fmac_f32 v148, v126, v143
    v_fmac_f32 v150, v127, v143
    buffer_store_dwordx4 v[148:151], v26, s[60:63], 0 offen sc1
    v_mul_f32 v144, v128, v129
    v_fmac_f32 v144, v130, v131
    v_fmac_f32 v144, v132, v133
    v_fmac_f32 v144, v134, v135
    v_fmac_f32 v144, v136, v137
    v_fmac_f32 v144, v138, v139
    v_fmac_f32 v144, v140, v141
    v_fmac_f32 v144, v142, v143
    s_mov_b64 exec, 1
    buffer_store_dwordx4 v[144:147], v26, s[60:63], 0 offen offset:1024 sc1
    s_mov_b64 exec, -1
    s_mov_b32 s76, 0
L_poll1:
    buffer_load_dwordx4 v[32:35], v29, s[60:63], 0 offen sc1
    buffer_load_dwordx4 v[36:39], v92, s[60:63], 0 offen offset:0 sc1
    buffer_load_dwordx4 v[40:43], v92, s[60:63], 0 offen offset:2048 sc1
    buffer_load_dwordx4 v[44:47], v92, s[60:63], s8 offen offset:0 sc1
    buffer_load_dwordx4 v[48:51], v92, s[60:63], s8 offen offset:2048 sc1
    buffer_load_dwordx4 v[52:55], v92, s[60:63], s77 offen offset:0 sc1
    buffer_load_dwordx4 v[56:59], v92, s[60:63], s77 offen offset:2048 sc1
    buffer_load_dwordx4 v[60:63], v92, s[60:63], s9 offen offset:0 sc1
    buffer_load_dwordx4 v[64:67], v92, s[60:63], s9 offen offset:2048 sc1
    s_waitcnt vmcnt(8)
    v_mov_b32 v12, v34
    s_nop 1
    v_max_f32_dpp v12, v12, v12 row_ror:1 row_mask:0xf bank_mask:0xf
    s_nop 1
    v_max_f32_dpp v12, v12, v12 row_ror:2 row_mask:0xf bank_mask:0xf
    s_nop 1
    v_max_f32_dpp v12, v12, v12 row_ror:4 row_mask:0xf bank_mask:0xf
    v_sub_f32 v12, v34, v12
    v_mul_f32 v12, s75, v12
    v_exp_f32 v12, v12
    s_nop 0
    v_mul_f32 v13, v12, v32
    s_nop 1
    v_add_f32_dpp v13, v13, v13 row_ror:1 row_mask:0xf bank_mask:0xf
    s_nop 1
    v_add_f32_dpp v13, v13, v13 row_ror:2 row_mask:0xf bank_mask:0xf
    s_nop 1
    v_add_f32_dpp v13, v13, v13 row_ror:4 row_mask:0xf bank_mask:0xf
    v_rcp_f32 v13, v13
    s_nop 0
    v_mul_f32 v12, v12, v13
    s_nop 1
    v_readlane_b32 s10, v12, 0
    v_readlane_b32 s11, v12, 1
    v_readlane_b32 s12, v12, 2
    v_readlane_b32 s13, v12, 3
    v_readlane_b32 s14, v12, 4
    v_readlane_b32 s15, v12, 5
    v_readlane_b32 s16, v12, 6
    v_readlane_b32 s17, v12, 7
    s_waitcnt vmcnt(0)
    v_xor_b32 v15, s66, v33
    v_xor_b32 v13, s67, v35
    v_or_b32 v14, v15, v13
    v_xor_b32 v15, s66, v37
    v_xor_b32 v13, s67, v39
    v_or3_b32 v14, v14, v15, v13
    v_xor_b32 v15, s66, v41
    v_xor_b32 v13, s67, v43
    v_or3_b32 v14, v14, v15, v13
    v_xor_b32 v15, s66, v45
    v_xor_b32 v13, s67, v47
    v_or3_b32 v14, v14, v15, v13
    v_xor_b32 v15, s66, v49
    v_xor_b32 v13, s67, v51
    v_or3_b32 v14, v14, v15, v13
    v_xor_b32 v15, s66, v53
    v_xor_b32 v13, s67, v55
    v_or3_b32 v14, v14, v15, v13
    v_xor_b32 v15, s66, v57
    v_xor_b32 v13, s67, v59
    v_or3_b32 v14, v14, v15, v13
    v_xor_b32 v15, s66, v61
    v_xor_b32 v13, s67, v63
    v_or3_b32 v14, v14, v15, v13
    v_xor_b32 v15, s66, v65
    v_xor_b32 v13, s67, v67
    v_or3_b32 v14, v14, v15, v13
    v_cmp_ne_u32 vcc, 0, v14
    s_nop 1
    s_cbranch_vccz L_poll1ok
    s_sleep 1
    s_add_u32 s76, s76, 1
    s_cmp_gt_u32 s76, 0x40000
    s_cbranch_scc0 L_poll1
L_poll1ok:
    v_mul_f32 v14, s10, v36
    v_mul_f32 v15, s10, v38
    v_fmac_f32 v14, s11, v40
    v_fmac_f32 v15, s11, v42
    v_fmac_f32 v14, s12, v44
    v_fmac_f32 v15, s12, v46
    v_fmac_f32 v14, s13, v48
    v_fmac_f32 v15, s13, v50
    v_fmac_f32 v14, s14, v52
    v_fmac_f32 v15, s14, v54
    v_fmac_f32 v14, s15, v56
    v_fmac_f32 v15, s15, v58
    v_fmac_f32 v14, s16, v60
    v_fmac_f32 v15, s16, v62
    v_fmac_f32 v14, s17, v64
    v_fmac_f32 v15, s17, v66
    v_cvt_pk_bf16_f32 v12, v14, v15
    v_lshlrev_b32 v14, 16, v12
    v_and_b32 v15, 0xffff0000, v12
    v_lshlrev_b32 v12, 3, v0
    ds_write_b64 v12, v[14:15] offset:10240
    s_waitcnt lgkmcnt(0)
    s_barrier
    s_barrier
    s_mov_b32 exec_lo, 0xffffffff
    s_mov_b32 exec_hi, 0xff
    ds_read_b64 v[112:113], v12 offset:5632
    ds_read_b64 v[114:115], v12 offset:6144
    ds_read_b64 v[116:117], v12 offset:6656
    ds_read_b64 v[118:119], v12 offset:7168
    ds_read_b64 v[120:121], v12 offset:7680
    ds_read_b64 v[122:123], v12 offset:8192
    ds_read_b64 v[124:125], v12 offset:8704
    ds_read_b64 v[126:127], v12 offset:9216
    s_waitcnt lgkmcnt(0)
    v_add_f32 v112, v112, v114
    v_add_f32 v113, v113, v115
    v_add_f32 v112, v112, v116
    v_add_f32 v113, v113, v117
    v_add_f32 v112, v112, v118
    v_add_f32 v113, v113, v119
    v_add_f32 v112, v112, v120
    v_add_f32 v113, v113, v121
    v_add_f32 v112, v112, v122
    v_add_f32 v113, v113, v123
    v_add_f32 v112, v112, v124
    v_add_f32 v113, v113, v125
    v_add_f32 v112, v112, v126
    v_add_f32 v113, v113, v127
    v_mov_b32 v148, v112
    v_mov_b32 v150, v113
    buffer_store_dwordx4 v[148:151], v27, s[60:63], 0 offen sc1
    s_mov_b64 exec, -1
    s_cmp_ge_u32 s3, 20
    s_cbranch_scc1 L_end
    s_mov_b32 s76, 0
L_poll2:
    buffer_load_dwordx4 v[112:115], v3, s[60:63], 0 offen sc1
    s_waitcnt vmcnt(0)
    v_xor_b32 v15, v30, v113
    v_xor_b32 v13, v31, v115
    v_or_b32 v14, v15, v13
    v_cmp_ne_u32 vcc, 0, v14
    s_nop 1
    s_cbranch_vccz L_poll2ok
    s_sleep 1
    s_add_u32 s76, s76, 1
    s_cmp_gt_u32 s76, 0x40000
    s_cbranch_scc0 L_poll2
L_poll2ok:
    v_add_f32_dpp v112, v112, v112 row_shr:1 row_mask:0xf bank_mask:0xf bound_ctrl:0
    v_add_f32_dpp v114, v114, v114 row_shr:1 row_mask:0xf bank_mask:0xf bound_ctrl:0
    s_nop 0
    v_add_f32_dpp v112, v112, v112 row_shr:2 row_mask:0xf bank_mask:0xf bound_ctrl:0
    v_add_f32_dpp v114, v114, v114 row_shr:2 row_mask:0xf bank_mask:0xf bound_ctrl:0
    s_nop 0
    v_add_f32_dpp v112, v112, v112 row_shr:4 row_mask:0xf bank_mask:0xf bound_ctrl:0
    v_add_f32_dpp v114, v114, v114 row_shr:4 row_mask:0xf bank_mask:0xf bound_ctrl:0
    s_nop 0
    v_add_f32_dpp v112, v112, v112 row_shr:8 row_mask:0xf bank_mask:0xf bound_ctrl:0
    v_add_f32_dpp v114, v114, v114 row_shr:8 row_mask:0xf bank_mask:0xf bound_ctrl:0
    s_nop 0
    v_add_f32_dpp v112, v112, v112 row_bcast:15 row_mask:0xa bank_mask:0xf
    v_add_f32_dpp v114, v114, v114 row_bcast:15 row_mask:0xa bank_mask:0xf
    v_cvt_pk_bf16_f32 v116, v112, v114
    s_mul_i32 s6, s4, 160
    s_lshl_b32 s7, s3, 3
    s_add_u32 s6, s6, s7
    v_lshrrev_b32 v12, 5, v0
    v_lshlrev_b32 v12, 2, v12
    v_add_u32 v12, s6, v12
    s_mov_b32 exec_lo, 0x80000000
    s_mov_b32 exec_hi, 0x80000000
    buffer_store_dword v116, v12, s[52:55], 0 offen
L_end:
L_exit:
    s_endpgm

.section .rodata,"a"
.p2align 6
.amdhsa_kernel standalone__sliding_block_cached__decode_kernel
  .amdhsa_next_free_vgpr 168
  .amdhsa_next_free_sgpr 102
  .amdhsa_accum_offset 168
  .amdhsa_group_segment_fixed_size 0
  .amdhsa_kernarg_size 64
  .amdhsa_user_sgpr_count 2
  .amdhsa_user_sgpr_kernarg_segment_ptr 1
  .amdhsa_system_sgpr_workgroup_id_x 1
.end_amdhsa_kernel
```
